```python
import torch

def _softmax(x, axis=-1):
    return torch.softmax(x, dim=axis)
def _gelu(x):
    return torch.nn.functional.gelu(x, approximate="tanh")
def _silu(x):
    return torch.nn.functional.silu(x)
def _sigmoid(x):
    return torch.sigmoid(x)
def _layernorm(x, axis=-1, eps=1e-5):
    m = x.mean(dim=axis, keepdim=True)
    v = x.var(dim=axis, keepdim=True, unbiased=False)
    return (x - m) / torch.sqrt(v + eps)
def _scatter_add(tgt, idx, src, axis=0):
    return tgt.clone().index_add_(axis, idx, src)
def _segment_sum(src, seg, n):
    out = torch.zeros((n,) + src.shape[1:], dtype=src.dtype)
    return out.index_add_(0, seg, src)
def _pad(x, pw):
    flat = tuple(v for pair in reversed(pw) for v in pair)
    return torch.nn.functional.pad(x, flat)

kernel_name = 'standalone__grn__sampling'

def setup_inputs():

    _w = (lambda a: (lambda t: t.to(torch.bfloat16) if t.is_floating_point() else t)(torch.as_tensor(a)))
    B, S, D = 1024, 32, 512
    return {
        "x": _w((lambda *s: torch.randn(*s, dtype=torch.bfloat16) * 0.05)(B, S, D)),
        "g": _w((lambda *s: torch.randn(*s, dtype=torch.bfloat16) * 0.4)(D) * 0.1),
        "b": _w((lambda *s: torch.randn(*s, dtype=torch.bfloat16) * 0.1)(D) * 0.1),
    }

def reference(x, g, b):
    gx = torch.sqrt((x * x).sum(axis=-2, keepdims=True))
    nx = gx / (gx.mean(axis=-1, keepdims=True) + 1e-6)
    return g * (x * nx) + b + x
```

```asm
; @launch grid=(1024,1,1) block=(256,1,1) lds=8192
.amdgcn_target "amdgcn-amd-amdhsa--gfx950"
.text
.globl standalone__grn__sampling_kernel
.p2align 8
.type standalone__grn__sampling_kernel,@function
standalone__grn__sampling_kernel:
    s_cmp_ge_u32 s2, 1024
    s_cbranch_scc1 L_end
    s_load_dwordx8 s[4:11], s[0:1], 0
    s_setprio 3
    v_and_b32 v2, 63, v0
    v_lshlrev_b32 v2, 4, v2
    v_lshrrev_b32 v3, 6, v0
    v_lshlrev_b32 v1, 4, v0
    v_add_u32 v1, 0x1000, v1
    v_lshl_or_b32 v3, v3, 11, v2
    s_lshl_b32 s3, s2, 15
    s_mov_b32 s12, 0xffff0000
    s_waitcnt lgkmcnt(0)
    s_add_u32 s4, s4, s3
    s_addc_u32 s5, s5, 0
    s_add_u32 s10, s10, s3
    s_addc_u32 s11, s11, 0
    global_load_dwordx4 v[8:11], v1, s[4:5] offset:-4096 nt
    global_load_dwordx4 v[12:15], v1, s[4:5] offset:0 nt
    s_add_u32 s14, s4, 8192
    s_addc_u32 s15, s5, 0
    global_load_dwordx4 v[16:19], v1, s[14:15] offset:-4096 nt
    global_load_dwordx4 v[20:23], v1, s[14:15] offset:0 nt
    s_add_u32 s16, s4, 16384
    s_addc_u32 s17, s5, 0
    global_load_dwordx4 v[24:27], v1, s[16:17] offset:-4096 nt
    global_load_dwordx4 v[28:31], v1, s[16:17] offset:0 nt
    s_add_u32 s18, s4, 24576
    s_addc_u32 s19, s5, 0
    global_load_dwordx4 v[32:35], v1, s[18:19] offset:-4096 nt
    global_load_dwordx4 v[36:39], v1, s[18:19] offset:0 nt
    s_add_u32 s20, s10, 8192
    s_addc_u32 s21, s11, 0
    s_add_u32 s22, s10, 16384
    s_addc_u32 s23, s11, 0
    s_add_u32 s24, s10, 24576
    s_addc_u32 s25, s11, 0
    global_load_dwordx4 v[80:83], v2, s[6:7]
    global_load_dwordx4 v[84:87], v2, s[8:9]
    s_waitcnt vmcnt(9)
    v_lshlrev_b32 v96, 16, v8
    v_and_b32 v97, s12, v8
    v_pk_mul_f32 v[40:41], v[96:97], v[96:97]
    v_lshlrev_b32 v98, 16, v9
    v_and_b32 v99, s12, v9
    v_pk_mul_f32 v[42:43], v[98:99], v[98:99]
    v_lshlrev_b32 v96, 16, v10
    v_and_b32 v97, s12, v10
    v_pk_mul_f32 v[44:45], v[96:97], v[96:97]
    v_lshlrev_b32 v98, 16, v11
    v_and_b32 v99, s12, v11
    v_pk_mul_f32 v[46:47], v[98:99], v[98:99]
    s_waitcnt vmcnt(8)
    v_lshlrev_b32 v96, 16, v12
    v_and_b32 v97, s12, v12
    v_pk_fma_f32 v[40:41], v[96:97], v[96:97], v[40:41]
    v_lshlrev_b32 v98, 16, v13
    v_and_b32 v99, s12, v13
    v_pk_fma_f32 v[42:43], v[98:99], v[98:99], v[42:43]
    v_lshlrev_b32 v96, 16, v14
    v_and_b32 v97, s12, v14
    v_pk_fma_f32 v[44:45], v[96:97], v[96:97], v[44:45]
    v_lshlrev_b32 v98, 16, v15
    v_and_b32 v99, s12, v15
    v_pk_fma_f32 v[46:47], v[98:99], v[98:99], v[46:47]
    s_waitcnt vmcnt(7)
    v_lshlrev_b32 v96, 16, v16
    v_and_b32 v97, s12, v16
    v_pk_fma_f32 v[40:41], v[96:97], v[96:97], v[40:41]
    v_lshlrev_b32 v98, 16, v17
    v_and_b32 v99, s12, v17
    v_pk_fma_f32 v[42:43], v[98:99], v[98:99], v[42:43]
    v_lshlrev_b32 v96, 16, v18
    v_and_b32 v97, s12, v18
    v_pk_fma_f32 v[44:45], v[96:97], v[96:97], v[44:45]
    v_lshlrev_b32 v98, 16, v19
    v_and_b32 v99, s12, v19
    v_pk_fma_f32 v[46:47], v[98:99], v[98:99], v[46:47]
    s_waitcnt vmcnt(6)
    v_lshlrev_b32 v96, 16, v20
    v_and_b32 v97, s12, v20
    v_pk_fma_f32 v[40:41], v[96:97], v[96:97], v[40:41]
    v_lshlrev_b32 v98, 16, v21
    v_and_b32 v99, s12, v21
    v_pk_fma_f32 v[42:43], v[98:99], v[98:99], v[42:43]
    v_lshlrev_b32 v96, 16, v22
    v_and_b32 v97, s12, v22
    v_pk_fma_f32 v[44:45], v[96:97], v[96:97], v[44:45]
    v_lshlrev_b32 v98, 16, v23
    v_and_b32 v99, s12, v23
    v_pk_fma_f32 v[46:47], v[98:99], v[98:99], v[46:47]
    s_waitcnt vmcnt(5)
    v_lshlrev_b32 v96, 16, v24
    v_and_b32 v97, s12, v24
    v_pk_fma_f32 v[40:41], v[96:97], v[96:97], v[40:41]
    v_lshlrev_b32 v98, 16, v25
    v_and_b32 v99, s12, v25
    v_pk_fma_f32 v[42:43], v[98:99], v[98:99], v[42:43]
    v_lshlrev_b32 v96, 16, v26
    v_and_b32 v97, s12, v26
    v_pk_fma_f32 v[44:45], v[96:97], v[96:97], v[44:45]
    v_lshlrev_b32 v98, 16, v27
    v_and_b32 v99, s12, v27
    v_pk_fma_f32 v[46:47], v[98:99], v[98:99], v[46:47]
    s_waitcnt vmcnt(4)
    v_lshlrev_b32 v96, 16, v28
    v_and_b32 v97, s12, v28
    v_pk_fma_f32 v[40:41], v[96:97], v[96:97], v[40:41]
    v_lshlrev_b32 v98, 16, v29
    v_and_b32 v99, s12, v29
    v_pk_fma_f32 v[42:43], v[98:99], v[98:99], v[42:43]
    v_lshlrev_b32 v96, 16, v30
    v_and_b32 v97, s12, v30
    v_pk_fma_f32 v[44:45], v[96:97], v[96:97], v[44:45]
    v_lshlrev_b32 v98, 16, v31
    v_and_b32 v99, s12, v31
    v_pk_fma_f32 v[46:47], v[98:99], v[98:99], v[46:47]
    s_waitcnt vmcnt(3)
    v_lshlrev_b32 v96, 16, v32
    v_and_b32 v97, s12, v32
    v_pk_fma_f32 v[40:41], v[96:97], v[96:97], v[40:41]
    v_lshlrev_b32 v98, 16, v33
    v_and_b32 v99, s12, v33
    v_pk_fma_f32 v[42:43], v[98:99], v[98:99], v[42:43]
    v_lshlrev_b32 v96, 16, v34
    v_and_b32 v97, s12, v34
    v_pk_fma_f32 v[44:45], v[96:97], v[96:97], v[44:45]
    v_lshlrev_b32 v98, 16, v35
    v_and_b32 v99, s12, v35
    v_pk_fma_f32 v[46:47], v[98:99], v[98:99], v[46:47]
    s_waitcnt vmcnt(2)
    v_lshlrev_b32 v96, 16, v36
    v_and_b32 v97, s12, v36
    v_pk_fma_f32 v[40:41], v[96:97], v[96:97], v[40:41]
    v_lshlrev_b32 v98, 16, v37
    v_and_b32 v99, s12, v37
    v_pk_fma_f32 v[42:43], v[98:99], v[98:99], v[42:43]
    v_lshlrev_b32 v96, 16, v38
    v_and_b32 v97, s12, v38
    v_pk_fma_f32 v[44:45], v[96:97], v[96:97], v[44:45]
    v_lshlrev_b32 v98, 16, v39
    v_and_b32 v99, s12, v39
    v_pk_fma_f32 v[46:47], v[98:99], v[98:99], v[46:47]
    ds_write_b128 v3, v[40:43]
    ds_write_b128 v3, v[44:47] offset:1024
    s_waitcnt vmcnt(0)
    v_lshlrev_b32 v88, 16, v84
    v_and_b32 v89, s12, v84
    v_lshlrev_b32 v90, 16, v85
    v_and_b32 v91, s12, v85
    v_lshlrev_b32 v92, 16, v86
    v_and_b32 v93, s12, v86
    v_lshlrev_b32 v94, 16, v87
    v_and_b32 v95, s12, v87
    v_lshlrev_b32 v104, 16, v80
    v_and_b32 v105, s12, v80
    v_lshlrev_b32 v106, 16, v81
    v_and_b32 v107, s12, v81
    v_lshlrev_b32 v108, 16, v82
    v_and_b32 v109, s12, v82
    v_lshlrev_b32 v110, 16, v83
    v_and_b32 v111, s12, v83
    s_waitcnt lgkmcnt(0)
    s_barrier
    ds_read_b128 v[48:51], v2 offset:0
    ds_read_b128 v[56:59], v2 offset:2048
    ds_read_b128 v[64:67], v2 offset:4096
    ds_read_b128 v[72:75], v2 offset:6144
    ds_read_b128 v[52:55], v2 offset:1024
    ds_read_b128 v[60:63], v2 offset:3072
    ds_read_b128 v[68:71], v2 offset:5120
    ds_read_b128 v[76:79], v2 offset:7168
    s_mov_b32 s13, 0x3b000000
    v_mov_b32 v7, 0x358637bd
    s_waitcnt lgkmcnt(4)
    v_pk_add_f32 v[48:49], v[48:49], v[56:57]
    v_pk_add_f32 v[64:65], v[64:65], v[72:73]
    v_pk_add_f32 v[50:51], v[50:51], v[58:59]
    v_pk_add_f32 v[66:67], v[66:67], v[74:75]
    v_pk_add_f32 v[40:41], v[48:49], v[64:65]
    v_pk_add_f32 v[42:43], v[50:51], v[66:67]
    v_sqrt_f32 v40, v40
    v_sqrt_f32 v41, v41
    v_sqrt_f32 v42, v42
    v_sqrt_f32 v43, v43
    s_waitcnt lgkmcnt(0)
    v_pk_add_f32 v[52:53], v[52:53], v[60:61]
    v_pk_add_f32 v[68:69], v[68:69], v[76:77]
    v_pk_add_f32 v[54:55], v[54:55], v[62:63]
    v_pk_add_f32 v[70:71], v[70:71], v[78:79]
    v_pk_add_f32 v[44:45], v[52:53], v[68:69]
    v_pk_add_f32 v[46:47], v[54:55], v[70:71]
    v_sqrt_f32 v44, v44
    v_sqrt_f32 v45, v45
    v_sqrt_f32 v46, v46
    v_sqrt_f32 v47, v47
    s_nop 0
    v_pk_add_f32 v[96:97], v[40:41], v[42:43]
    v_pk_add_f32 v[98:99], v[44:45], v[46:47]
    v_pk_add_f32 v[96:97], v[96:97], v[98:99]
    v_add_f32 v96, v96, v97
    v_pk_mul_f32 v[40:41], v[40:41], v[104:105]
    v_pk_mul_f32 v[42:43], v[42:43], v[106:107]
    v_pk_mul_f32 v[44:45], v[44:45], v[108:109]
    v_pk_mul_f32 v[46:47], v[46:47], v[110:111]
    s_nop 1
    v_add_f32_dpp v96, v96, v96 quad_perm:[1,0,3,2] row_mask:0xf bank_mask:0xf
    s_nop 1
    v_add_f32_dpp v96, v96, v96 quad_perm:[2,3,0,1] row_mask:0xf bank_mask:0xf
    s_nop 1
    v_add_f32_dpp v96, v96, v96 row_half_mirror row_mask:0xf bank_mask:0xf
    s_nop 1
    v_add_f32_dpp v96, v96, v96 row_mirror row_mask:0xf bank_mask:0xf
    v_mov_b32 v97, v96
    s_nop 1
    v_permlane16_swap_b32 v96, v97
    s_nop 1
    v_add_f32 v96, v96, v97
    v_mov_b32 v97, v96
    s_nop 1
    v_permlane32_swap_b32 v96, v97
    s_nop 1
    v_add_f32 v96, v96, v97
    v_fma_f32 v96, v96, s13, v7
    v_rcp_f32 v96, v96
    s_nop 0
    v_pk_fma_f32 v[40:41], v[40:41], v[96:97], 1.0 op_sel_hi:[1,0,0]
    v_pk_fma_f32 v[42:43], v[42:43], v[96:97], 1.0 op_sel_hi:[1,0,0]
    v_pk_fma_f32 v[44:45], v[44:45], v[96:97], 1.0 op_sel_hi:[1,0,0]
    v_pk_fma_f32 v[46:47], v[46:47], v[96:97], 1.0 op_sel_hi:[1,0,0]
    s_setprio 0
    v_lshlrev_b32 v96, 16, v8
    v_and_b32 v97, s12, v8
    v_pk_fma_f32 v[96:97], v[96:97], v[40:41], v[88:89]
    v_cvt_pk_bf16_f32 v8, v96, v97
    v_lshlrev_b32 v98, 16, v9
    v_and_b32 v99, s12, v9
    v_pk_fma_f32 v[98:99], v[98:99], v[42:43], v[90:91]
    v_cvt_pk_bf16_f32 v9, v98, v99
    v_lshlrev_b32 v96, 16, v10
    v_and_b32 v97, s12, v10
    v_pk_fma_f32 v[96:97], v[96:97], v[44:45], v[92:93]
    v_cvt_pk_bf16_f32 v10, v96, v97
    v_lshlrev_b32 v98, 16, v11
    v_and_b32 v99, s12, v11
    v_pk_fma_f32 v[98:99], v[98:99], v[46:47], v[94:95]
    v_cvt_pk_bf16_f32 v11, v98, v99
    global_store_dwordx4 v1, v[8:11], s[10:11] offset:-4096 sc1
    v_lshlrev_b32 v100, 16, v12
    v_and_b32 v101, s12, v12
    v_pk_fma_f32 v[100:101], v[100:101], v[40:41], v[88:89]
    v_cvt_pk_bf16_f32 v12, v100, v101
    v_lshlrev_b32 v102, 16, v13
    v_and_b32 v103, s12, v13
    v_pk_fma_f32 v[102:103], v[102:103], v[42:43], v[90:91]
    v_cvt_pk_bf16_f32 v13, v102, v103
    v_lshlrev_b32 v100, 16, v14
    v_and_b32 v101, s12, v14
    v_pk_fma_f32 v[100:101], v[100:101], v[44:45], v[92:93]
    v_cvt_pk_bf16_f32 v14, v100, v101
    v_lshlrev_b32 v102, 16, v15
    v_and_b32 v103, s12, v15
    v_pk_fma_f32 v[102:103], v[102:103], v[46:47], v[94:95]
    v_cvt_pk_bf16_f32 v15, v102, v103
    global_store_dwordx4 v1, v[12:15], s[10:11] offset:0 sc1
    v_lshlrev_b32 v96, 16, v16
    v_and_b32 v97, s12, v16
    v_pk_fma_f32 v[96:97], v[96:97], v[40:41], v[88:89]
    v_cvt_pk_bf16_f32 v16, v96, v97
    v_lshlrev_b32 v98, 16, v17
    v_and_b32 v99, s12, v17
    v_pk_fma_f32 v[98:99], v[98:99], v[42:43], v[90:91]
    v_cvt_pk_bf16_f32 v17, v98, v99
    v_lshlrev_b32 v96, 16, v18
    v_and_b32 v97, s12, v18
    v_pk_fma_f32 v[96:97], v[96:97], v[44:45], v[92:93]
    v_cvt_pk_bf16_f32 v18, v96, v97
    v_lshlrev_b32 v98, 16, v19
    v_and_b32 v99, s12, v19
    v_pk_fma_f32 v[98:99], v[98:99], v[46:47], v[94:95]
    v_cvt_pk_bf16_f32 v19, v98, v99
    global_store_dwordx4 v1, v[16:19], s[20:21] offset:-4096 sc1
    v_lshlrev_b32 v100, 16, v20
    v_and_b32 v101, s12, v20
    v_pk_fma_f32 v[100:101], v[100:101], v[40:41], v[88:89]
    v_cvt_pk_bf16_f32 v20, v100, v101
    v_lshlrev_b32 v102, 16, v21
    v_and_b32 v103, s12, v21
    v_pk_fma_f32 v[102:103], v[102:103], v[42:43], v[90:91]
    v_cvt_pk_bf16_f32 v21, v102, v103
    v_lshlrev_b32 v100, 16, v22
    v_and_b32 v101, s12, v22
    v_pk_fma_f32 v[100:101], v[100:101], v[44:45], v[92:93]
    v_cvt_pk_bf16_f32 v22, v100, v101
    v_lshlrev_b32 v102, 16, v23
    v_and_b32 v103, s12, v23
    v_pk_fma_f32 v[102:103], v[102:103], v[46:47], v[94:95]
    v_cvt_pk_bf16_f32 v23, v102, v103
    global_store_dwordx4 v1, v[20:23], s[20:21] offset:0 sc1
    v_lshlrev_b32 v96, 16, v24
    v_and_b32 v97, s12, v24
    v_pk_fma_f32 v[96:97], v[96:97], v[40:41], v[88:89]
    v_cvt_pk_bf16_f32 v24, v96, v97
    v_lshlrev_b32 v98, 16, v25
    v_and_b32 v99, s12, v25
    v_pk_fma_f32 v[98:99], v[98:99], v[42:43], v[90:91]
    v_cvt_pk_bf16_f32 v25, v98, v99
    v_lshlrev_b32 v96, 16, v26
    v_and_b32 v97, s12, v26
    v_pk_fma_f32 v[96:97], v[96:97], v[44:45], v[92:93]
    v_cvt_pk_bf16_f32 v26, v96, v97
    v_lshlrev_b32 v98, 16, v27
    v_and_b32 v99, s12, v27
    v_pk_fma_f32 v[98:99], v[98:99], v[46:47], v[94:95]
    v_cvt_pk_bf16_f32 v27, v98, v99
    global_store_dwordx4 v1, v[24:27], s[22:23] offset:-4096 sc1
    v_lshlrev_b32 v100, 16, v28
    v_and_b32 v101, s12, v28
    v_pk_fma_f32 v[100:101], v[100:101], v[40:41], v[88:89]
    v_cvt_pk_bf16_f32 v28, v100, v101
    v_lshlrev_b32 v102, 16, v29
    v_and_b32 v103, s12, v29
    v_pk_fma_f32 v[102:103], v[102:103], v[42:43], v[90:91]
    v_cvt_pk_bf16_f32 v29, v102, v103
    v_lshlrev_b32 v100, 16, v30
    v_and_b32 v101, s12, v30
    v_pk_fma_f32 v[100:101], v[100:101], v[44:45], v[92:93]
    v_cvt_pk_bf16_f32 v30, v100, v101
    v_lshlrev_b32 v102, 16, v31
    v_and_b32 v103, s12, v31
    v_pk_fma_f32 v[102:103], v[102:103], v[46:47], v[94:95]
    v_cvt_pk_bf16_f32 v31, v102, v103
    global_store_dwordx4 v1, v[28:31], s[22:23] offset:0 sc1
    v_lshlrev_b32 v96, 16, v32
    v_and_b32 v97, s12, v32
    v_pk_fma_f32 v[96:97], v[96:97], v[40:41], v[88:89]
    v_cvt_pk_bf16_f32 v32, v96, v97
    v_lshlrev_b32 v98, 16, v33
    v_and_b32 v99, s12, v33
    v_pk_fma_f32 v[98:99], v[98:99], v[42:43], v[90:91]
    v_cvt_pk_bf16_f32 v33, v98, v99
    v_lshlrev_b32 v96, 16, v34
    v_and_b32 v97, s12, v34
    v_pk_fma_f32 v[96:97], v[96:97], v[44:45], v[92:93]
    v_cvt_pk_bf16_f32 v34, v96, v97
    v_lshlrev_b32 v98, 16, v35
    v_and_b32 v99, s12, v35
    v_pk_fma_f32 v[98:99], v[98:99], v[46:47], v[94:95]
    v_cvt_pk_bf16_f32 v35, v98, v99
    global_store_dwordx4 v1, v[32:35], s[24:25] offset:-4096 sc1
    v_lshlrev_b32 v100, 16, v36
    v_and_b32 v101, s12, v36
    v_pk_fma_f32 v[100:101], v[100:101], v[40:41], v[88:89]
    v_cvt_pk_bf16_f32 v36, v100, v101
    v_lshlrev_b32 v102, 16, v37
    v_and_b32 v103, s12, v37
    v_pk_fma_f32 v[102:103], v[102:103], v[42:43], v[90:91]
    v_cvt_pk_bf16_f32 v37, v102, v103
    v_lshlrev_b32 v100, 16, v38
    v_and_b32 v101, s12, v38
    v_pk_fma_f32 v[100:101], v[100:101], v[44:45], v[92:93]
    v_cvt_pk_bf16_f32 v38, v100, v101
    v_lshlrev_b32 v102, 16, v39
    v_and_b32 v103, s12, v39
    v_pk_fma_f32 v[102:103], v[102:103], v[46:47], v[94:95]
    v_cvt_pk_bf16_f32 v39, v102, v103
    global_store_dwordx4 v1, v[36:39], s[24:25] offset:0 sc1
L_end:
    s_endpgm
.section .rodata,"a"
.p2align 6
.amdhsa_kernel standalone__grn__sampling_kernel
  .amdhsa_next_free_vgpr 112
  .amdhsa_next_free_sgpr 56
  .amdhsa_accum_offset 112
  .amdhsa_group_segment_fixed_size 0
  .amdhsa_kernarg_size 48
  .amdhsa_user_sgpr_count 2
  .amdhsa_user_sgpr_kernarg_segment_ptr 1
  .amdhsa_system_sgpr_workgroup_id_x 1
  .amdhsa_float_denorm_mode_32 3
.end_amdhsa_kernel
```
